```python
import torch

def _softmax(x, axis=-1):
    return torch.softmax(x, dim=axis)
def _gelu(x):
    return torch.nn.functional.gelu(x, approximate="tanh")
def _silu(x):
    return torch.nn.functional.silu(x)
def _sigmoid(x):
    return torch.sigmoid(x)
def _layernorm(x, axis=-1, eps=1e-5):
    m = x.mean(dim=axis, keepdim=True)
    v = x.var(dim=axis, keepdim=True, unbiased=False)
    return (x - m) / torch.sqrt(v + eps)
def _scatter_add(tgt, idx, src, axis=0):
    return tgt.clone().index_add_(axis, idx, src)
def _segment_sum(src, seg, n):
    out = torch.zeros((n,) + src.shape[1:], dtype=src.dtype)
    return out.index_add_(0, seg, src)
def _pad(x, pw):
    flat = tuple(v for pair in reversed(pw) for v in pair)
    return torch.nn.functional.pad(x, flat)

kernel_name = 'standalone__deepnorm__prompt'

def setup_inputs():

    _w = (lambda a: (lambda t: t.to(torch.bfloat16) if t.is_floating_point() else t)(torch.as_tensor(a)))
    B, S, D = 4, 2048, 448
    return {
        "x": _w((lambda *s: torch.randn(*s, dtype=torch.bfloat16) * 0.05)(B, S, D)),
        "f": _w((lambda *s: torch.randn(*s, dtype=torch.bfloat16) * 0.05)(B, S, D)),
        "g": _w((lambda *s: torch.randn(*s, dtype=torch.bfloat16) * 0.05)(D) + 1.0),
        "b": _w((lambda *s: torch.randn(*s, dtype=torch.bfloat16) * 0.4)(D)),
        "alpha": _w(float(2.0)),
    }

def reference(x, f, g, b, alpha):
    return _layernorm(alpha * x + f, axis=-1) * g + b
```

```asm
; @launch grid=(256,1,1) block=(512,1,1) lds=4096
.amdgcn_target "amdgcn-amd-amdhsa--gfx950"
.text
.p2align 12
.globl standalone__deepnorm__prompt_kernel
.p2align 8
.type standalone__deepnorm__prompt_kernel,@function
standalone__deepnorm__prompt_kernel:
    s_load_dwordx4 s[4:7], s[0:1], 0
    v_readfirstlane_b32 s32, v0
    v_lshrrev_b32 v1, 4, v0
    s_mul_i32 s3, s2, 28672
    v_mul_u32_u24 v1, 896, v1
    v_and_b32 v2, 15, v0
    v_and_b32 v3, 63, v0
    v_add_u32 v1, s3, v1
    v_and_b32 v58, 3, v0
    v_lshl_add_u32 v0, v2, 3, v1
    v_lshl_add_u32 v1, v2, 4, v1
    v_min_u32 v59, 55, v3
    v_lshlrev_b32 v3, 5, v3
    v_lshlrev_b32 v59, 4, v59
    v_lshlrev_b32 v58, 4, v58
    v_lshlrev_b32 v56, 5, v2
    v_lshlrev_b32 v57, 4, v2
    s_movk_i32 s28, 0x3f80
    s_mov_b32 s29, 0
    s_mov_b32 s27, 0
    s_cmpk_ge_u32 s2, 256
    s_cbranch_scc1 L_exit
    s_cmpk_ge_u32 s32, 256
    s_cbranch_scc1 L_touch
    s_bitcmp1_b32 s32, 6
    s_waitcnt lgkmcnt(0)
    global_load_dwordx4 v[4:7], v1, s[4:5] nt
    s_load_dwordx8 s[8:15], s[0:1], 16
    global_load_dwordx4 v[18:21], v1, s[6:7] nt
    global_load_dwordx4 v[8:11], v1, s[4:5] offset:256 nt
    global_load_dwordx4 v[22:25], v1, s[6:7] offset:256 nt
    s_waitcnt lgkmcnt(0)
    s_cselect_b64 s[8:9], s[10:11], s[8:9]
    global_load_dwordx4 v[32:35], v59, s[8:9]
    s_cselect_b32 s33, 2048, 0
    s_load_dword s26, s[12:13], 0
    s_barrier
    global_load_dwordx4 v[12:15], v1, s[4:5] offset:512 nt
    global_load_dwordx4 v[26:29], v1, s[6:7] offset:512 nt
    global_load_dwordx2 v[16:17], v0, s[4:5] offset:768 nt
    global_load_dwordx2 v[30:31], v0, s[6:7] offset:768 nt
    s_barrier
    s_mov_b32 s30, 0xffff0000
    v_add_u32 v3, s33, v3
    s_waitcnt vmcnt(4)
    v_lshlrev_b32 v36, 16, v32
    v_and_b32 v37, s30, v32
    v_lshlrev_b32 v38, 16, v33
    v_and_b32 v39, s30, v33
    v_lshlrev_b32 v40, 16, v34
    v_and_b32 v41, s30, v34
    v_lshlrev_b32 v42, 16, v35
    v_and_b32 v43, s30, v35
    ds_write_b128 v3, v[36:39]
    ds_write_b128 v3, v[40:43] offset:16
    s_barrier
    s_branch L_join
L_g2:
    s_waitcnt lgkmcnt(0)
    s_load_dwordx4 s[12:15], s[0:1], 32
    s_barrier
    s_waitcnt lgkmcnt(0)
    s_load_dword s26, s[12:13], 0
    s_barrier
    global_load_dwordx4 v[4:7], v1, s[4:5] offset:0 nt
    global_load_dwordx4 v[18:21], v1, s[6:7] offset:0 nt
    global_load_dwordx4 v[8:11], v1, s[4:5] offset:256 nt
    global_load_dwordx4 v[22:25], v1, s[6:7] offset:256 nt
    s_barrier
    global_load_dwordx4 v[12:15], v1, s[4:5] offset:512 nt
    global_load_dwordx4 v[26:29], v1, s[6:7] offset:512 nt
    global_load_dwordx2 v[16:17], v0, s[4:5] offset:768 nt
    global_load_dwordx2 v[30:31], v0, s[6:7] offset:768 nt
L_join:
    v_lshlrev_b64 v[118:119], v58, s[28:29]
    v_mov_b32 v2, 0x3727c5ac
    s_mov_b32 s28, 0x3b124925
    s_waitcnt lgkmcnt(0)
    s_barrier
    s_lshl_b32 s31, s26, 16
    s_lshr_b32 s26, s31, 16
    ds_read_b128 v[60:63], v56 offset:0
    ds_read_b128 v[64:67], v56 offset:16
    ds_read_b128 v[88:91], v56 offset:2048
    ds_read_b128 v[92:95], v56 offset:2064
    ds_read_b128 v[68:71], v56 offset:512
    ds_read_b128 v[72:75], v56 offset:528
    ds_read_b128 v[96:99], v56 offset:2560
    ds_read_b128 v[100:103], v56 offset:2576
    ds_read_b128 v[76:79], v56 offset:1024
    ds_read_b128 v[80:83], v56 offset:1040
    ds_read_b128 v[104:107], v56 offset:3072
    ds_read_b128 v[108:111], v56 offset:3088
    ds_read_b128 v[84:87], v57 offset:1536
    ds_read_b128 v[112:115], v57 offset:3584
    v_lshlrev_b64 v[116:117], v58, s[26:27]
    s_cmpk_lt_u32 s32, 256
    s_branch L_main
L_p2a:
    v_pk_fma_f32 v[32:33], v[32:33], v[126:127], v[126:127] op_sel:[0,0,1] op_sel_hi:[1,0,1]
    v_pk_fma_f32 v[34:35], v[34:35], v[126:127], v[126:127] op_sel:[0,0,1] op_sel_hi:[1,0,1]
    v_pk_fma_f32 v[36:37], v[36:37], v[126:127], v[126:127] op_sel:[0,0,1] op_sel_hi:[1,0,1]
    v_pk_fma_f32 v[38:39], v[38:39], v[126:127], v[126:127] op_sel:[0,0,1] op_sel_hi:[1,0,1]
    v_pk_fma_f32 v[32:33], v[32:33], v[60:61], v[88:89]
    v_pk_fma_f32 v[34:35], v[34:35], v[62:63], v[90:91]
    v_pk_fma_f32 v[36:37], v[36:37], v[64:65], v[92:93]
    v_pk_fma_f32 v[38:39], v[38:39], v[66:67], v[94:95]
    v_cvt_pk_bf16_f32 v4, v32, v33
    v_cvt_pk_bf16_f32 v5, v34, v35
    v_cvt_pk_bf16_f32 v6, v36, v37
    v_cvt_pk_bf16_f32 v7, v38, v39
    v_pk_fma_f32 v[40:41], v[40:41], v[126:127], v[126:127] op_sel:[0,0,1] op_sel_hi:[1,0,1]
    v_pk_fma_f32 v[42:43], v[42:43], v[126:127], v[126:127] op_sel:[0,0,1] op_sel_hi:[1,0,1]
    v_pk_fma_f32 v[44:45], v[44:45], v[126:127], v[126:127] op_sel:[0,0,1] op_sel_hi:[1,0,1]
    v_pk_fma_f32 v[46:47], v[46:47], v[126:127], v[126:127] op_sel:[0,0,1] op_sel_hi:[1,0,1]
    v_pk_fma_f32 v[40:41], v[40:41], v[68:69], v[96:97]
    v_pk_fma_f32 v[42:43], v[42:43], v[70:71], v[98:99]
    v_pk_fma_f32 v[44:45], v[44:45], v[72:73], v[100:101]
    v_pk_fma_f32 v[46:47], v[46:47], v[74:75], v[102:103]
    v_cvt_pk_bf16_f32 v8, v40, v41
    v_cvt_pk_bf16_f32 v9, v42, v43
    v_cvt_pk_bf16_f32 v10, v44, v45
    v_cvt_pk_bf16_f32 v11, v46, v47
    v_pk_fma_f32 v[48:49], v[48:49], v[126:127], v[126:127] op_sel:[0,0,1] op_sel_hi:[1,0,1]
    v_pk_fma_f32 v[50:51], v[50:51], v[126:127], v[126:127] op_sel:[0,0,1] op_sel_hi:[1,0,1]
    v_pk_fma_f32 v[52:53], v[52:53], v[126:127], v[126:127] op_sel:[0,0,1] op_sel_hi:[1,0,1]
    v_pk_fma_f32 v[54:55], v[54:55], v[126:127], v[126:127] op_sel:[0,0,1] op_sel_hi:[1,0,1]
    v_pk_fma_f32 v[48:49], v[48:49], v[76:77], v[104:105]
    v_pk_fma_f32 v[50:51], v[50:51], v[78:79], v[106:107]
    v_pk_fma_f32 v[52:53], v[52:53], v[80:81], v[108:109]
    v_pk_fma_f32 v[54:55], v[54:55], v[82:83], v[110:111]
    v_cvt_pk_bf16_f32 v12, v48, v49
    v_cvt_pk_bf16_f32 v13, v50, v51
    v_cvt_pk_bf16_f32 v14, v52, v53
    v_cvt_pk_bf16_f32 v15, v54, v55
    v_pk_fma_f32 v[56:57], v[56:57], v[126:127], v[126:127] op_sel:[0,0,1] op_sel_hi:[1,0,1]
    v_pk_fma_f32 v[58:59], v[58:59], v[126:127], v[126:127] op_sel:[0,0,1] op_sel_hi:[1,0,1]
    v_pk_fma_f32 v[56:57], v[56:57], v[84:85], v[112:113]
    v_pk_fma_f32 v[58:59], v[58:59], v[86:87], v[114:115]
    v_cvt_pk_bf16_f32 v16, v56, v57
    v_cvt_pk_bf16_f32 v17, v58, v59
    s_barrier
    global_store_dwordx4 v1, v[4:7], s[14:15] offset:0 nt
    global_store_dwordx4 v1, v[8:11], s[14:15] offset:256 nt
    global_store_dwordx4 v1, v[12:15], s[14:15] offset:512 nt
    global_store_dwordx2 v0, v[16:17], s[14:15] offset:768 nt
L_exit:
    s_endpgm
    .org standalone__deepnorm__prompt_kernel+1152, 0
L_touch:
    s_branch L_g2
    s_nop 0
L_main:
    s_waitcnt vmcnt(6)
    v_lshlrev_b32 v124, 16, v4
    v_lshlrev_b32_e64 v125, 16, v18
    v_fma_f32 v124, -s31, v124, -v125
    s_nop 0
    s_nop 0
    v_mov_b32_dpp v120, v124 row_newbcast:0 row_mask:0xf bank_mask:0xf
    v_mov_b32_dpp v121, v124 row_newbcast:0 row_mask:0xf bank_mask:0xf
    v_mov_b32_dpp v122, v124 row_newbcast:0 row_mask:0xf bank_mask:0xf
    v_mov_b32_dpp v123, v124 row_newbcast:0 row_mask:0xf bank_mask:0xf
    s_nop 0
    s_nop 0
    v_mfma_f32_4x4x4_16b_bf16 v[32:35], v[116:117], v[4:5], v[120:123]
    v_mfma_f32_4x4x4_16b_bf16 v[36:39], v[116:117], v[6:7], v[120:123]
    s_nop 0
    s_nop 0
    v_mfma_f32_4x4x4_16b_bf16 v[32:35], v[118:119], v[18:19], v[32:35]
    v_mfma_f32_4x4x4_16b_bf16 v[36:39], v[118:119], v[20:21], v[36:39]
    s_nop 1
    s_nop 1
    v_pk_add_f32 v[124:125], v[32:33], v[34:35]
    v_pk_mul_f32 v[126:127], v[32:33], v[32:33]
    v_pk_fma_f32 v[126:127], v[34:35], v[34:35], v[126:127]
    s_waitcnt vmcnt(4)
    v_add_f32 v124, v124, v36
    v_mfma_f32_4x4x4_16b_bf16 v[40:43], v[116:117], v[8:9], v[120:123]
    v_fmac_f32_e64 v126, v36, v36
    v_mfma_f32_4x4x4_16b_bf16 v[44:47], v[116:117], v[10:11], v[120:123]
    v_add_f32_e64 v125, v125, v37
    v_mfma_f32_4x4x4_16b_bf16 v[40:43], v[118:119], v[22:23], v[40:43]
    v_fmac_f32_e64 v127, v37, v37
    v_mfma_f32_4x4x4_16b_bf16 v[44:47], v[118:119], v[24:25], v[44:47]
    v_add_f32 v124, v124, v38
    v_fmac_f32 v126, v38, v38
    v_add_f32 v125, v125, v39
    v_fmac_f32 v127, v39, v39
    v_pk_add_f32 v[124:125], v[124:125], v[40:41]
    v_pk_fma_f32 v[126:127], v[40:41], v[40:41], v[126:127]
    v_pk_add_f32 v[124:125], v[124:125], v[42:43]
    v_pk_fma_f32 v[126:127], v[42:43], v[42:43], v[126:127]
    s_waitcnt vmcnt(2)
    v_add_f32 v124, v124, v44
    v_mfma_f32_4x4x4_16b_bf16 v[48:51], v[116:117], v[12:13], v[120:123]
    v_fmac_f32_e64 v126, v44, v44
    v_mfma_f32_4x4x4_16b_bf16 v[52:55], v[116:117], v[14:15], v[120:123]
    v_add_f32_e64 v125, v125, v45
    v_mfma_f32_4x4x4_16b_bf16 v[48:51], v[118:119], v[26:27], v[48:51]
    v_fmac_f32_e64 v127, v45, v45
    v_mfma_f32_4x4x4_16b_bf16 v[52:55], v[118:119], v[28:29], v[52:55]
    v_add_f32 v124, v124, v46
    v_fmac_f32 v126, v46, v46
    v_add_f32 v125, v125, v47
    v_fmac_f32 v127, v47, v47
    v_pk_add_f32 v[124:125], v[124:125], v[48:49]
    v_pk_fma_f32 v[126:127], v[48:49], v[48:49], v[126:127]
    v_pk_add_f32 v[124:125], v[124:125], v[50:51]
    v_pk_fma_f32 v[126:127], v[50:51], v[50:51], v[126:127]
    s_waitcnt vmcnt(0)
    s_cbranch_scc1 L_nb
    s_barrier
L_nb:
    v_add_f32 v124, v124, v52
    v_mfma_f32_4x4x4_16b_bf16 v[56:59], v[116:117], v[16:17], v[120:123]
    v_fmac_f32 v126, v52, v52
    v_add_f32 v125, v125, v53
    v_mfma_f32_4x4x4_16b_bf16 v[56:59], v[118:119], v[30:31], v[56:59]
    v_fmac_f32 v127, v53, v53
    v_add_f32 v124, v124, v54
    v_fmac_f32 v126, v54, v54
    v_add_f32 v125, v125, v55
    v_fmac_f32_e64 v127, v55, v55
    v_pk_add_f32 v[124:125], v[124:125], v[56:57]
    v_pk_fma_f32 v[126:127], v[56:57], v[56:57], v[126:127]
    v_pk_add_f32 v[124:125], v[124:125], v[58:59]
    v_pk_fma_f32 v[126:127], v[58:59], v[58:59], v[126:127]
    v_add_f32 v124, v124, v125
    v_add_f32 v126, v126, v127
    v_nop_e64
    v_add_f32_dpp v124, v124, v124 quad_perm:[1,0,3,2] row_mask:0xf bank_mask:0xf
    v_add_f32_dpp v126, v126, v126 quad_perm:[1,0,3,2] row_mask:0xf bank_mask:0xf
    v_nop_e64
    v_add_f32_dpp v124, v124, v124 quad_perm:[2,3,0,1] row_mask:0xf bank_mask:0xf
    v_add_f32_dpp v126, v126, v126 quad_perm:[2,3,0,1] row_mask:0xf bank_mask:0xf
    v_nop_e64
    v_add_f32_dpp v124, v124, v124 row_half_mirror row_mask:0xf bank_mask:0xf
    v_add_f32_dpp v126, v126, v126 row_half_mirror row_mask:0xf bank_mask:0xf
    v_nop_e64
    v_add_f32_dpp v124, v124, v124 row_mirror row_mask:0xf bank_mask:0xf
    v_add_f32_dpp v126, v126, v126 row_mirror row_mask:0xf bank_mask:0xf
    v_mul_f32_e64 v124, s28, v124
    v_fma_f32 v126, v126, s28, v2
    v_fma_f32 v126, -v124, v124, v126
    v_rsq_f32 v126, v126
    s_waitcnt lgkmcnt(0)
    v_mul_f32 v127, -v124, v126
    s_cbranch_scc1 L_p2a
    s_nop 0
    v_pk_fma_f32 v[32:33], v[32:33], v[126:127], v[126:127] op_sel:[0,0,1] op_sel_hi:[1,0,1]
    v_pk_fma_f32 v[34:35], v[34:35], v[126:127], v[126:127] op_sel:[0,0,1] op_sel_hi:[1,0,1]
    v_pk_fma_f32 v[36:37], v[36:37], v[126:127], v[126:127] op_sel:[0,0,1] op_sel_hi:[1,0,1]
    v_pk_fma_f32 v[38:39], v[38:39], v[126:127], v[126:127] op_sel:[0,0,1] op_sel_hi:[1,0,1]
    v_pk_fma_f32 v[32:33], v[32:33], v[60:61], v[88:89]
    v_pk_fma_f32 v[34:35], v[34:35], v[62:63], v[90:91]
    v_pk_fma_f32 v[36:37], v[36:37], v[64:65], v[92:93]
    v_pk_fma_f32 v[38:39], v[38:39], v[66:67], v[94:95]
    v_cvt_pk_bf16_f32 v4, v32, v33
    v_cvt_pk_bf16_f32 v5, v34, v35
    v_cvt_pk_bf16_f32 v6, v36, v37
    v_cvt_pk_bf16_f32 v7, v38, v39
    global_store_dwordx4 v1, v[4:7], s[14:15] offset:0 nt
    v_pk_fma_f32 v[40:41], v[40:41], v[126:127], v[126:127] op_sel:[0,0,1] op_sel_hi:[1,0,1]
    v_pk_fma_f32 v[42:43], v[42:43], v[126:127], v[126:127] op_sel:[0,0,1] op_sel_hi:[1,0,1]
    v_pk_fma_f32 v[44:45], v[44:45], v[126:127], v[126:127] op_sel:[0,0,1] op_sel_hi:[1,0,1]
    v_pk_fma_f32 v[46:47], v[46:47], v[126:127], v[126:127] op_sel:[0,0,1] op_sel_hi:[1,0,1]
    v_pk_fma_f32 v[40:41], v[40:41], v[68:69], v[96:97]
    v_pk_fma_f32 v[42:43], v[42:43], v[70:71], v[98:99]
    v_pk_fma_f32 v[44:45], v[44:45], v[72:73], v[100:101]
    v_pk_fma_f32 v[46:47], v[46:47], v[74:75], v[102:103]
    v_cvt_pk_bf16_f32 v8, v40, v41
    v_cvt_pk_bf16_f32 v9, v42, v43
    v_cvt_pk_bf16_f32 v10, v44, v45
    v_cvt_pk_bf16_f32 v11, v46, v47
    global_store_dwordx4 v1, v[8:11], s[14:15] offset:256 nt
    v_pk_fma_f32 v[48:49], v[48:49], v[126:127], v[126:127] op_sel:[0,0,1] op_sel_hi:[1,0,1]
    v_pk_fma_f32 v[50:51], v[50:51], v[126:127], v[126:127] op_sel:[0,0,1] op_sel_hi:[1,0,1]
    v_pk_fma_f32 v[52:53], v[52:53], v[126:127], v[126:127] op_sel:[0,0,1] op_sel_hi:[1,0,1]
    v_pk_fma_f32 v[54:55], v[54:55], v[126:127], v[126:127] op_sel:[0,0,1] op_sel_hi:[1,0,1]
    v_pk_fma_f32 v[48:49], v[48:49], v[76:77], v[104:105]
    v_pk_fma_f32 v[50:51], v[50:51], v[78:79], v[106:107]
    v_pk_fma_f32 v[52:53], v[52:53], v[80:81], v[108:109]
    v_pk_fma_f32 v[54:55], v[54:55], v[82:83], v[110:111]
    v_cvt_pk_bf16_f32 v12, v48, v49
    v_cvt_pk_bf16_f32 v13, v50, v51
    v_cvt_pk_bf16_f32 v14, v52, v53
    v_cvt_pk_bf16_f32 v15, v54, v55
    global_store_dwordx4 v1, v[12:15], s[14:15] offset:512 nt
    v_pk_fma_f32 v[56:57], v[56:57], v[126:127], v[126:127] op_sel:[0,0,1] op_sel_hi:[1,0,1]
    v_pk_fma_f32 v[58:59], v[58:59], v[126:127], v[126:127] op_sel:[0,0,1] op_sel_hi:[1,0,1]
    v_pk_fma_f32 v[56:57], v[56:57], v[84:85], v[112:113]
    v_pk_fma_f32 v[58:59], v[58:59], v[86:87], v[114:115]
    v_cvt_pk_bf16_f32 v16, v56, v57
    v_cvt_pk_bf16_f32 v17, v58, v59
    global_store_dwordx2 v0, v[16:17], s[14:15] offset:768 nt
    s_endpgm

.section .rodata,"a"
.p2align 6
.amdhsa_kernel standalone__deepnorm__prompt_kernel
  .amdhsa_next_free_vgpr 128
  .amdhsa_next_free_sgpr 34
  .amdhsa_accum_offset 128
  .amdhsa_group_segment_fixed_size 0
  .amdhsa_kernarg_size 64
  .amdhsa_user_sgpr_count 2
  .amdhsa_user_sgpr_kernarg_segment_ptr 1
  .amdhsa_system_sgpr_workgroup_id_x 1
  .amdhsa_float_denorm_mode_32 3
.end_amdhsa_kernel
```
